```python
import torch

def _softmax(x, axis=-1):
    return torch.softmax(x, dim=axis)
def _gelu(x):
    return torch.nn.functional.gelu(x, approximate="tanh")
def _silu(x):
    return torch.nn.functional.silu(x)
def _sigmoid(x):
    return torch.sigmoid(x)
def _layernorm(x, axis=-1, eps=1e-5):
    m = x.mean(dim=axis, keepdim=True)
    v = x.var(dim=axis, keepdim=True, unbiased=False)
    return (x - m) / torch.sqrt(v + eps)
def _scatter_add(tgt, idx, src, axis=0):
    return tgt.clone().index_add_(axis, idx, src)
def _segment_sum(src, seg, n):
    out = torch.zeros((n,) + src.shape[1:], dtype=src.dtype)
    return out.index_add_(0, seg, src)
def _pad(x, pw):
    flat = tuple(v for pair in reversed(pw) for v in pair)
    return torch.nn.functional.pad(x, flat)

kernel_name = 'parallel_sum__gqa_block_cached__glu_gated_swiglu__decode'

def setup_inputs():

    _w = (lambda a: (lambda t: t.to(torch.bfloat16) if t.is_floating_point() else t)(torch.as_tensor(a)))
    def _A_setup():
        B, Sq, D = 1, 1, 640
        Hq, Hkv, Sk, Dh = 32, 32, 4096, 192
        assert Hq % Hkv == 0, (Hq, Hkv)
        return {
            "x": _w((lambda *s: torch.randn(*s, dtype=torch.bfloat16) * 0.05)(B, Sq, D)),
            "k_cache": _w((lambda *s: torch.randn(*s, dtype=torch.bfloat16) * 1.6)(B, Hkv, Sk, Dh)),
            "v_cache": _w((lambda *s: torch.randn(*s, dtype=torch.bfloat16) * 0.8)(B, Hkv, Sk, Dh)),
            "wq": _w((lambda *s: torch.randn(*s, dtype=torch.bfloat16) * 1.6)(D, Hq * Dh) * (D ** -0.5)),
            "wo": _w((lambda *s: torch.randn(*s, dtype=torch.bfloat16) * 0.8)(Hq * Dh, D) * ((Hq * Dh) ** -0.5)),
        }
    _A_in = _A_setup()

    def _B_setup():
        B, S, D, F = 1, 1, 640, 1536
        return {
            "x": _w((lambda *s: torch.randn(*s, dtype=torch.bfloat16) * 0.05)(B, S, D)),
            "w1": _w((lambda *s: torch.randn(*s, dtype=torch.bfloat16) * 0.4)(D, F) * (2.0 / D) ** 0.5),
            "w3": _w((lambda *s: torch.randn(*s, dtype=torch.bfloat16) * 0.4)(D, F) * (2.0 / D) ** 0.5),
            "w2": _w((lambda *s: torch.randn(*s, dtype=torch.bfloat16) * 0.4)(F, D) * (2.0 / F) ** 0.5),
        }
    _B_in = _B_setup()

    return {
        "A_x": _A_in["x"],
        "A_k_cache": _A_in["k_cache"],
        "A_v_cache": _A_in["v_cache"],
        "A_wq": _A_in["wq"],
        "A_wo": _A_in["wo"],
        "B_x": _B_in["x"],
        "B_w1": _B_in["w1"],
        "B_w3": _B_in["w3"],
        "B_w2": _B_in["w2"],
    }

def reference(A_x, A_k_cache, A_v_cache, A_wq, A_wo, B_x, B_w1, B_w3, B_w2):
    def _A_ref(x, k_cache, v_cache, wq, wo):
        B, Sq, D = x.shape
        Hq, Dh = 32, 192
        Hkv = k_cache.shape[1]
        rep = Hq // Hkv
        q = (lambda x, *d: x.permute(*d))((x @ wq).reshape(B, Sq, Hq, Dh), 0, 2, 1, 3)
        k = (lambda x, n, axis: torch.repeat_interleave(x, n, dim=axis))(k_cache, rep, axis=1)
        v = (lambda x, n, axis: torch.repeat_interleave(x, n, dim=axis))(v_cache, rep, axis=1)
        scores = torch.einsum("bhqd,bhkd->bhqk", q, k) * (Dh ** -0.5)
        p = _softmax(scores, axis=-1)
        o = torch.einsum("bhqk,bhkd->bhqd", p, v)
        return (lambda x, *d: x.permute(*d))(o, 0, 2, 1, 3).reshape(B, Sq, Hq * Dh) @ wo

    def _B_ref(x, w1, w3, w2):
        gate = torch.einsum("bsd,df->bsf", x, w1)
        up = torch.einsum("bsd,df->bsf", x, w3)
        h = _silu(gate) * up
        out = torch.einsum("bsf,fd->bsd", h, w2)
        return out

    x = A_x
    xn = _layernorm(x, axis=-1)
    return x + _A_ref(xn, A_k_cache, A_v_cache, A_wq, A_wo) + _B_ref(xn, B_w1, B_w3, B_w2)
```

```asm
; @launch grid=(256,1,1) block=(512,1,1) lds=32768
.amdgcn_target "amdgcn-amd-amdhsa--gfx950"
.text
.globl parallel_sum__gqa_block_cached__glu_gated_swiglu__decode_kernel
.p2align 8
.type parallel_sum__gqa_block_cached__glu_gated_swiglu__decode_kernel,@function
parallel_sum__gqa_block_cached__glu_gated_swiglu__decode_kernel:
    s_cmpk_ge_u32 s2, 256
    s_cbranch_scc1 L_end
    s_load_dwordx16 s[4:19], s[0:1], 0
    s_load_dwordx8 s[20:27], s[0:1], 64
    s_memrealtime s[82:83]
    v_lshrrev_b32 v48, 6, v0
    v_and_b32 v1, 63, v0
    v_readfirstlane_b32 s52, v48
    s_and_b32 s53, s2, 7
    s_lshr_b32 s54, s2, 3
    s_lshl_b32 s55, s53, 5
    s_add_u32 s55, s55, s54
    v_lshrrev_b32 v2, 3, v1
    v_and_b32 v3, 7, v1
    s_lshr_b32 s56, s55, 3
    s_and_b32 s57, s55, 7
    v_mov_b32 v22, 0
    v_mov_b32 v23, 0
    ds_write_b64 v22, v[22:23] offset:25088
    s_max_u32 s59, s54, 2
    s_sub_u32 s59, s59, 2
    s_mul_i32 s65, s59, 52
    s_lshr_b32 s65, s65, 8
    s_mul_i32 s60, s65, 5
    s_sub_u32 s66, s59, s60
    s_lshl_b32 s59, s66, 7
    s_mul_i32 s60, s52, 40
    s_add_u32 s59, s59, s60
    s_cmp_eq_u32 s52, 5
    s_cselect_b32 s60, 8, 0
    s_sub_u32 s59, s59, s60
    s_sub_u32 s59, s59, 192
    s_lshr_b32 s60, s65, 1
    s_mul_i32 s61, s53, 3
    s_add_u32 s60, s60, s61
    s_lshl_b32 s60, s60, 7
    s_cmp_lt_u32 s54, 2
    s_cselect_b32 s60, 1073741824, s60
    s_mul_i32 s61, s57, 80
    s_lshl_b32 s62, s52, 4
    s_add_u32 s61, s61, s62
    s_mul_i32 s62, s56, 384
    s_cmp_lt_u32 s52, 5
    s_cselect_b32 s59, s61, s59
    s_cselect_b32 s60, s62, s60
    s_cselect_b32 s61, 12, 3
    s_cselect_b32 s62, 4, 3
    s_cselect_b32 s68, 1, 192
    s_lshl_b32 s61, s61, 10
    s_mul_i32 s38, s61, 640
    s_mov_b32 s39, 0x20000
    v_add_u32 v48, s59, v2
    v_mul_lo_u32 v5, v48, s61
    v_lshl_add_u32 v49, v3, 4, s60
    v_add_u32 v5, v5, v49
    s_lshl_b32 s76, s68, 7
    s_lshl_b32 s77, s68, 8
    s_waitcnt lgkmcnt(0)
    s_bitcmp1_b32 s65, 0
    s_cselect_b64 s[36:37], s[18:19], s[16:17]
    s_cmp_lt_u32 s52, 5
    s_cselect_b64 s[36:37], s[10:11], s[36:37]
    buffer_load_dwordx4 v[92:95], v5, s[36:39], 0 offen nt
    buffer_load_dwordx4 v[96:99], v5, s[36:39], s76 offen nt
    buffer_load_dwordx4 v[100:103], v5, s[36:39], s77 offen nt
    s_mov_b64 s[28:29], s[6:7]
    s_load_dword s58, s[26:27], 0
    s_mov_b64 s[44:45], s[4:5]
    s_mov_b32 s46, 1280
    s_mov_b32 s47, 0x20000
    v_lshlrev_b32 v11, 4, v1
    v_lshlrev_b32 v52, 2, v1
    v_add_lshl_u32 v50, v1, s59, 1
    buffer_load_dwordx4 v[56:59], v11, s[44:47], 0 offen
    buffer_load_dword v60, v52, s[44:47], 0 offen offset:1024
    buffer_load_ushort v8, v50, s[44:47], 0 offen
    s_barrier
    s_mul_i32 s62, s62, 24576
    v_add_u32 v6, s62, v5
    s_cmp_lt_u32 s52, 6
    s_cselect_b32 s62, 0, 1073741824
    v_or_b32 v7, s62, v6
    s_lshl_b32 s59, s55, 3
    s_add_u32 s59, s59, s52
    s_mul_i32 s59, s59, 24576
    v_mul_u32_u24 v4, 384, v2
    v_lshl_add_u32 v49, v3, 4, s59
    v_add_u32 v4, v4, v49
    s_mov_b32 s30, 50331648
    s_mov_b32 s31, 0x20000
    v_mov_b32 v23, 1
    s_mov_b64 s[32:33], s[8:9]
    s_mov_b32 s34, 50331648
    s_mov_b32 s35, 0x20000
    s_mov_b64 s[40:41], s[26:27]
    s_mov_b32 s42, 8388608
    s_mov_b32 s43, 0x20000
    s_mov_b64 s[48:49], s[22:23]
    s_mov_b32 s50, 1280
    s_mov_b32 s51, 0x20000
    s_mov_b32 s14, 7864320
    s_mov_b32 s15, 0x20000
    s_mov_b32 s22, 1966080
    s_mov_b32 s23, 0x20000
    s_mov_b32 s16, 6144
    s_mov_b32 s17, 12288
    s_mov_b32 s18, 18432
    s_mov_b32 s19, s82
    s_mov_b32 s63, 1048576
    s_mov_b32 s64, 0
    s_mov_b32 s71, 0xffffff00
    s_mov_b32 s78, 0x00ff00ff
    s_mov_b32 s79, 0xff00ff00
    v_and_b32 v48, 1, v1
    v_lshlrev_b32 v48, 4, v48
    v_mov_b32 v49, 0xffff
    v_lshlrev_b32 v48, v48, v49
    v_lshrrev_b32 v49, 1, v3
    v_cmp_eq_u32 vcc, 0, v49
    s_nop 1
    v_cndmask_b32 v24, 0, v48, vcc
    v_cmp_eq_u32 vcc, 1, v49
    s_nop 1
    v_cndmask_b32 v25, 0, v48, vcc
    v_cmp_eq_u32 vcc, 2, v49
    s_nop 1
    v_cndmask_b32 v26, 0, v48, vcc
    v_cmp_eq_u32 vcc, 3, v49
    s_nop 1
    v_cndmask_b32 v27, 0, v48, vcc
    v_lshrrev_b32 v50, 5, v1
    v_mul_u32_u24 v48, 768, v50
    v_bfe_u32 v49, v1, 4, 1
    v_lshl_add_u32 v49, v3, 1, v49
    v_lshl_add_u32 v49, v49, 4, v48
    s_mul_i32 s59, s52, 1536
    v_add_u32 v9, s59, v49
    v_and_b32 v51, 31, v1
    s_sub_u32 s62, s52, 6
    s_min_u32 s62, s62, s52
    s_lshl_b32 s59, s62, 7
    v_lshl_add_u32 v49, v51, 2, s59
    v_add_u32 v10, v48, v49
    s_mul_i32 s59, s56, 6
    s_add_u32 s59, s59, s52
    s_lshl_b32 s59, s59, 10
    s_lshl_b32 s60, s57, 4
    s_add_u32 s59, s59, s60
    s_add_u32 s59, s59, 65536
    s_lshl_b32 s69, s53, 13
    s_add_u32 s69, s69, 262144
    s_and_b32 s60, s65, 6
    s_add_u32 s60, s60, s62
    s_mul_i32 s60, s60, 1280
    s_and_b32 s61, s65, 1
    s_mul_i32 s61, s61, 5
    s_add_u32 s61, s61, s66
    s_lshl_b32 s61, s61, 4
    s_add_u32 s60, s60, s61
    s_add_u32 s60, s60, s69
    s_cmp_lt_u32 s54, 2
    s_cselect_b32 s60, 1073741824, s60
    s_cmp_lt_u32 s52, 6
    s_cselect_b32 s59, s59, 1073741824
    s_cselect_b32 s60, 1073741824, s60
    v_lshrrev_b32 v48, 2, v51
    v_lshl_add_u32 v49, v48, 7, s59
    v_mul_u32_u24 v52, 160, v48
    v_add_u32 v52, s60, v52
    v_cmp_gt_u32 vcc, 32, v1
    v_and_b32 v53, 3, v1
    s_nop 0
    v_cndmask_b32 v49, v52, v49, vcc
    v_lshl_add_u32 v12, v53, 2, v49
    s_waitcnt vmcnt(5)
    buffer_load_dwordx4 v[104:107], v6, s[36:39], 0 offen nt
    s_waitcnt vmcnt(5)
    buffer_load_dwordx4 v[108:111], v6, s[36:39], s76 offen nt
    s_waitcnt vmcnt(5)
    buffer_load_dwordx4 v[112:115], v7, s[36:39], s77 offen nt
    s_mul_i32 s59, s54, 26
    s_lshr_b32 s59, s59, 8
    s_mul_i32 s60, s59, 10
    s_sub_u32 s66, s54, s60
    s_min_u32 s61, s59, 2
    s_lshl_b32 s61, s61, 3
    s_add_u32 s62, s61, s52
    s_mul_i32 s61, s53, 24
    s_add_u32 s65, s62, s61
    s_lshl_b32 s61, s66, 7
    s_cmp_lt_u32 s54, 30
    s_cselect_b32 s61, s61, 1073741824
    v_lshl_add_u32 v48, v3, 4, s61
    s_mul_i32 s61, s65, 10240
    v_mul_u32_u24 v49, 1280, v2
    v_add_u32 v49, s61, v49
    v_add_u32 v16, v48, v49
    v_lshl_add_u32 v15, v49, 2, v48
    s_lshl_b32 s60, s66, 2
    s_add_u32 s60, s60, s52
    s_lshl_b32 s60, s60, 12
    s_mul_i32 s61, s53, 3
    s_add_u32 s61, s61, s59
    s_lshl_b32 s61, s61, 7
    s_add_u32 s60, s60, s61
    s_add_u32 s60, s60, 1048576
    v_lshl_add_u32 v17, v51, 2, s60
    v_lshl_add_u32 v17, v50, 13, v17
    s_min_u32 s59, s52, 5
    s_mul_i32 s60, s56, 6
    s_add_u32 s59, s59, s60
    s_lshl_b32 s59, s59, 10
    s_add_u32 s68, s59, 65536
    s_mul_i32 s62, s62, 320
    v_lshrrev_b32 v48, 4, v1
    v_mul_u32_u24 v48, 80, v48
    v_add_u32 v48, s62, v48
    v_and_b32 v49, 15, v1
    v_cmp_gt_u32 vcc, 5, v49
    v_mov_b32 v49, 7680
    s_nop 0
    v_cndmask_b32 v48, v49, v48, vcc
    v_lshl_add_u32 v18, v3, 4, v48
    s_waitcnt vmcnt(2)
    buffer_load_dwordx4 v[140:143], v4, s[28:31], 0 offen offset:0 nt
    s_waitcnt vmcnt(4)
    v_lshlrev_b32 v68, 16, v56
    v_and_b32 v69, 0xffff0000, v56
    v_lshlrev_b32 v70, 16, v57
    v_and_b32 v71, 0xffff0000, v57
    v_lshlrev_b32 v72, 16, v58
    v_and_b32 v73, 0xffff0000, v58
    v_lshlrev_b32 v74, 16, v59
    v_and_b32 v75, 0xffff0000, v59
    v_lshlrev_b32 v76, 16, v60
    v_and_b32 v77, 0xffff0000, v60
    v_add_f32 v48, v68, v69
    v_add_f32 v49, v70, v71
    v_add_f32 v48, v48, v72
    v_add_f32 v49, v49, v73
    v_add_f32 v48, v48, v74
    v_add_f32 v49, v49, v75
    v_add_f32 v48, v48, v76
    v_add_f32 v49, v49, v77
    v_add_f32 v48, v48, v49
    s_nop 1
    v_add_f32_dpp v48, v48, v48 quad_perm:[1,0,3,2] row_mask:0xf bank_mask:0xf
    s_nop 1
    v_add_f32_dpp v48, v48, v48 quad_perm:[2,3,0,1] row_mask:0xf bank_mask:0xf
    s_nop 1
    v_add_f32_dpp v48, v48, v48 row_half_mirror row_mask:0xf bank_mask:0xf
    s_nop 1
    v_add_f32_dpp v48, v48, v48 row_ror:8 row_mask:0xf bank_mask:0xf
    s_nop 1
    v_add_f32_dpp v48, v48, v48 row_bcast:15 row_mask:0xa bank_mask:0xf
    s_nop 1
    v_add_f32_dpp v48, v48, v48 row_bcast:31 row_mask:0xc bank_mask:0xf
    s_nop 0
    v_readlane_b32 s59, v48, 63
    v_mov_b32 v50, 0x3acccccd
    s_waitcnt vmcnt(2)
    buffer_load_dwordx4 v[144:147], v4, s[28:31], 0 offen offset:128 nt
    v_mul_f32 v51, s59, v50
    v_sub_f32 v68, v68, v51
    v_sub_f32 v69, v69, v51
    v_sub_f32 v70, v70, v51
    v_sub_f32 v71, v71, v51
    v_sub_f32 v72, v72, v51
    v_sub_f32 v73, v73, v51
    v_sub_f32 v74, v74, v51
    v_sub_f32 v75, v75, v51
    v_sub_f32 v76, v76, v51
    v_sub_f32 v77, v77, v51
    v_mul_f32 v48, v68, v68
    v_mul_f32 v49, v69, v69
    v_fmac_f32 v48, v70, v70
    v_fmac_f32 v49, v71, v71
    v_fmac_f32 v48, v72, v72
    v_fmac_f32 v49, v73, v73
    v_fmac_f32 v48, v74, v74
    v_fmac_f32 v49, v75, v75
    v_fmac_f32 v48, v76, v76
    v_fmac_f32 v49, v77, v77
    v_add_f32 v48, v48, v49
    s_waitcnt vmcnt(2)
    buffer_load_dwordx4 v[148:151], v4, s[28:31], 0 offen offset:256 nt
    s_memrealtime s[80:81]
    v_add_f32_dpp v48, v48, v48 quad_perm:[1,0,3,2] row_mask:0xf bank_mask:0xf
    s_nop 1
    v_add_f32_dpp v48, v48, v48 quad_perm:[2,3,0,1] row_mask:0xf bank_mask:0xf
    s_nop 1
    v_add_f32_dpp v48, v48, v48 row_half_mirror row_mask:0xf bank_mask:0xf
    s_nop 1
    v_add_f32_dpp v48, v48, v48 row_ror:8 row_mask:0xf bank_mask:0xf
    s_nop 1
    v_add_f32_dpp v48, v48, v48 row_bcast:15 row_mask:0xa bank_mask:0xf
    s_nop 1
    v_add_f32_dpp v48, v48, v48 row_bcast:31 row_mask:0xc bank_mask:0xf
    s_nop 0
    v_readlane_b32 s59, v48, 63
    v_lshlrev_b32 v8, 16, v8
    v_cvt_pk_bf16_f32 v51, v51, v51
    v_and_b32 v51, 0xffff0000, v51
    v_mul_f32 v50, s59, v50
    v_sub_f32 v8, v8, v51
    s_waitcnt vmcnt(3) lgkmcnt(0)
    s_sub_u32 s80, s80, s19
    s_cmpk_gt_i32 s80, 248
    s_cbranch_scc1 L_deep_1
    s_sub_u32 s19, s19, 2
    s_waitcnt vmcnt(1)
L_deep_1:
    buffer_load_dwordx4 v[152:155], v4, s[28:31], 0 offen offset:3072 nt
    s_memrealtime s[80:81]
    v_cvt_pk_bf16_f32 v50, v50, v50
    v_and_b32 v50, 0xffff0000, v50
    v_cvt_pk_bf16_f32 v8, v8, v8
    v_and_b32 v8, 0xffff0000, v8
    v_add_f32 v50, 0x3727c5ac, v50
    v_cvt_pk_bf16_f32 v50, v50, v50
    v_and_b32 v50, 0xffff0000, v50
    v_sqrt_f32 v50, v50
    s_nop 0
    v_cvt_pk_bf16_f32 v50, v50, v50
    v_and_b32 v50, 0xffff0000, v50
    v_rcp_f32 v52, v50
    s_nop 0
    v_mul_f32 v48, v8, v52
    v_fma_f32 v49, -v48, v50, v8
    v_fma_f32 v48, v49, v52, v48
    v_cvt_pk_bf16_f32 v8, v48, v48
    v_lshlrev_b32 v48, 2, v2
    ds_bpermute_b32 v60, v48, v8 offset:0
    ds_bpermute_b32 v61, v48, v8 offset:32
    ds_bpermute_b32 v62, v48, v8 offset:64
    ds_bpermute_b32 v63, v48, v8 offset:96
    ds_bpermute_b32 v64, v48, v8 offset:128
    ds_bpermute_b32 v65, v48, v8 offset:160
    s_waitcnt vmcnt(3) lgkmcnt(0)
    s_sub_u32 s80, s80, s19
    s_cmpk_gt_i32 s80, 323
    s_cbranch_scc1 L_deep_2
    s_sub_u32 s19, s19, 2
    s_waitcnt vmcnt(2)
L_deep_2:
    buffer_load_dwordx4 v[156:159], v4, s[28:31], 0 offen offset:3200 nt
    s_memrealtime s[80:81]
    s_waitcnt lgkmcnt(0)
    s_add_u32 s58, s58, 0x01010101
    s_bfe_u32 s72, s58, 0x80000
    s_bfe_u32 s73, s58, 0x80008
    s_bfe_u32 s74, s58, 0x80010
    s_bfe_u32 s75, s58, 0x80018
    s_getreg_b32 s59, hwreg(HW_REG_XCC_ID, 0, 4)
    s_lshl_b32 s59, s59, 28
    s_and_b32 s70, s58, 0x0fffffff
    s_or_b32 s70, s70, s59
    v_and_b32 v48, 3, v1
    v_lshlrev_b32 v48, 3, v48
    v_bfe_u32 v13, s58, v48, 8
    s_add_u32 s58, s58, 0x01010101
    v_bfe_u32 v14, s58, v48, 8
    s_mov_b32 s67, 24
    v_and_b32 v28, v60, v24
    v_and_b32 v29, v60, v25
    v_and_b32 v30, v60, v26
    v_and_b32 v31, v60, v27
    v_and_b32 v32, v61, v24
    v_and_b32 v33, v61, v25
    v_and_b32 v34, v61, v26
    v_and_b32 v35, v61, v27
    s_cmp_lt_u32 s52, 5
    s_cbranch_scc1 L_s1q
    v_mfma_f32_16x16x32_bf16 v[80:83], v[28:31], v[92:95], 0
    v_and_b32 v28, v62, v24
    v_and_b32 v29, v62, v25
    v_and_b32 v30, v62, v26
    v_and_b32 v31, v62, v27
    v_mfma_f32_16x16x32_bf16 v[80:83], v[32:35], v[96:99], v[80:83]
    v_and_b32 v32, v63, v24
    v_and_b32 v33, v63, v25
    v_and_b32 v34, v63, v26
    v_and_b32 v35, v63, v27
    v_mfma_f32_16x16x32_bf16 v[80:83], v[28:31], v[100:103], v[80:83]
    v_and_b32 v28, v64, v24
    v_and_b32 v29, v64, v25
    v_and_b32 v30, v64, v26
    v_and_b32 v31, v64, v27
    v_mfma_f32_16x16x32_bf16 v[80:83], v[32:35], v[104:107], v[80:83]
    v_and_b32 v32, v65, v24
    v_and_b32 v33, v65, v25
    v_and_b32 v34, v65, v26
    v_and_b32 v35, v65, v27
    v_mfma_f32_16x16x32_bf16 v[80:83], v[28:31], v[108:111], v[80:83]
    s_nop 0
    v_mfma_f32_16x16x32_bf16 v[80:83], v[32:35], v[112:115], v[80:83]
    s_nop 0
    s_branch L_s1back
L_s1q:
    v_mfma_f32_16x16x32_bf16 v[80:83], v[28:31], v[92:95], 0
    v_mfma_f32_16x16x32_bf16 v[84:87], v[28:31], v[96:99], 0
    v_mfma_f32_16x16x32_bf16 v[88:91], v[28:31], v[100:103], 0
    v_mfma_f32_16x16x32_bf16 v[80:83], v[32:35], v[104:107], v[80:83]
    v_mfma_f32_16x16x32_bf16 v[84:87], v[32:35], v[108:111], v[84:87]
    v_mfma_f32_16x16x32_bf16 v[88:91], v[32:35], v[112:115], v[88:91]
L_s1back:
    s_mov_b64 exec, s[78:79]
    s_nop 4
    ds_write_b128 v9, v[80:83] offset:0
    ds_write_b128 v9, v[84:87] offset:256
    ds_write_b128 v9, v[88:91] offset:512
    s_mov_b64 exec, 1
    ds_add_u32 v22, v23 offset:25088
    s_mov_b64 exec, -1
    s_waitcnt vmcnt(3) lgkmcnt(0)
    s_sub_u32 s80, s80, s19
    s_cmpk_gt_i32 s80, 332
    s_cbranch_scc1 L_deep_3
    s_sub_u32 s19, s19, 2
    s_waitcnt vmcnt(2)
L_deep_3:
    buffer_load_dwordx4 v[160:163], v4, s[28:31], 0 offen offset:3328 nt
    s_memrealtime s[80:81]
    s_waitcnt vmcnt(3) lgkmcnt(0)
    s_sub_u32 s80, s80, s19
    s_cmpk_gt_i32 s80, 337
    s_cbranch_scc1 L_deep_4
    s_sub_u32 s19, s19, 2
    s_waitcnt vmcnt(1)
L_deep_4:
    buffer_load_dwordx4 v[164:167], v4, s[28:31], s16 offen offset:0 nt
    s_memrealtime s[80:81]
    s_waitcnt vmcnt(3) lgkmcnt(0)
    s_sub_u32 s80, s80, s19
    s_cmpk_gt_i32 s80, 411
    s_cbranch_scc1 L_deep_5
    s_sub_u32 s19, s19, 2
    s_waitcnt vmcnt(2)
L_deep_5:
    buffer_load_dwordx4 v[168:171], v4, s[28:31], s16 offen offset:128 nt
    s_memrealtime s[80:81]
L_await_6:
    ds_read_b32 v19, v22 offset:25088
    ds_read2st64_b32 v[48:49], v10 offset0:0 offset1:6
    ds_read2st64_b32 v[50:51], v10 offset0:12 offset1:18
    ds_read2st64_b32 v[52:53], v10 offset0:24 offset1:30
    ds_read2st64_b32 v[54:55], v10 offset0:36 offset1:42
    s_sub_u32 s63, s63, 1
    s_cbranch_scc1 L_end
    s_waitcnt lgkmcnt(0)
    v_cmp_ne_u32 vcc, 8, v19
    s_cbranch_vccnz L_await_6
    v_add_f32 v48, v48, v49
    v_add_f32 v50, v50, v51
    v_add_f32 v53, v53, v54
    v_add_f32 v48, v48, v52
    v_add_f32 v53, v53, v55
    v_add_f32 v48, v48, v50
    s_lshl_b32 s59, s54, 2
    s_add_u32 s59, s59, s69
    s_add_u32 s59, s59, 7680
    v_permlane32_swap_b32 v48, v53
    v_add_f32 v48, v48, v53
    v_and_or_b32 v13, v48, s71, v13
    s_cmp_eq_u32 s52, 7
    s_cselect_b64 exec, 1, 0
    v_mov_b32 v13, s70
    v_mov_b32 v12, s59
    s_mov_b64 exec, -1
    buffer_store_dword v13, v12, s[40:43], 0 offen
    s_waitcnt vmcnt(4) lgkmcnt(0)
    s_sub_u32 s80, s80, s19
    s_cmpk_gt_i32 s80, 421
    s_cbranch_scc1 L_deep_7
    s_sub_u32 s19, s19, 2
    s_waitcnt vmcnt(3)
L_deep_7:
    buffer_load_dwordx4 v[172:175], v4, s[28:31], s16 offen offset:256 nt
    s_memrealtime s[80:81]
    s_waitcnt vmcnt(4) lgkmcnt(0)
    s_sub_u32 s80, s80, s19
    s_cmpk_gt_i32 s80, 426
    s_cbranch_scc1 L_deep_8
    s_sub_u32 s19, s19, 2
    s_waitcnt vmcnt(2)
L_deep_8:
    buffer_load_dwordx4 v[176:179], v4, s[28:31], s16 offen offset:3072 nt
    s_memrealtime s[80:81]
    s_waitcnt vmcnt(4) lgkmcnt(0)
    s_sub_u32 s80, s80, s19
    s_cmpk_gt_i32 s80, 500
    s_cbranch_scc1 L_deep_9
    s_sub_u32 s19, s19, 2
    s_waitcnt vmcnt(3)
L_deep_9:
    buffer_load_dwordx4 v[180:183], v4, s[28:31], s16 offen offset:3200 nt
    s_memrealtime s[80:81]
    s_waitcnt vmcnt(4) lgkmcnt(0)
    s_sub_u32 s80, s80, s19
    s_cmpk_gt_i32 s80, 510
    s_cbranch_scc1 L_deep_10
    s_sub_u32 s19, s19, 2
    s_waitcnt vmcnt(2)
L_deep_10:
    buffer_load_dwordx4 v[184:187], v4, s[28:31], s16 offen offset:3328 nt
    s_memrealtime s[80:81]
    s_waitcnt vmcnt(3) lgkmcnt(0)
    s_sub_u32 s80, s80, s19
    s_cmpk_gt_i32 s80, 514
    s_cbranch_scc1 L_deep_11
    s_sub_u32 s19, s19, 2
    s_waitcnt vmcnt(1)
L_deep_11:
    buffer_load_dwordx4 v[188:191], v4, s[28:31], s17 offen offset:0 nt
    s_memrealtime s[80:81]
    s_waitcnt vmcnt(3) lgkmcnt(0)
    s_sub_u32 s80, s80, s19
    s_cmpk_gt_i32 s80, 589
    s_cbranch_scc1 L_deep_12
    s_sub_u32 s19, s19, 2
    s_waitcnt vmcnt(2)
L_deep_12:
    buffer_load_dwordx4 v[192:195], v4, s[28:31], s17 offen offset:128 nt
    s_memrealtime s[80:81]
    buffer_load_dwordx4 v[40:43], v11, s[40:43], s68 offen sc1
    buffer_load_dwordx4 v[44:47], v18, s[40:43], s69 offen sc1
    v_and_b32 v49, 15, v1
    v_cmp_gt_u32 vcc, 5, v49
    v_mov_b32 v49, s70
    v_mov_b32 v50, 0xff
    v_mov_b32 v28, s72
    v_cndmask_b32 v28, v49, v28, vcc
    v_mov_b32 v29, s73
    v_cndmask_b32 v29, v49, v29, vcc
    v_mov_b32 v30, s74
    v_cndmask_b32 v30, v49, v30, vcc
    v_mov_b32 v31, s75
    v_cndmask_b32 v31, v49, v31, vcc
    v_cndmask_b32 v32, -1, v50, vcc
    s_waitcnt vmcnt(5) lgkmcnt(0)
    s_sub_u32 s80, s80, s19
    s_cmpk_gt_i32 s80, 599
    s_cbranch_scc1 L_deep_13
    s_sub_u32 s19, s19, 2
    s_waitcnt vmcnt(4)
L_deep_13:
    buffer_load_dwordx4 v[196:199], v4, s[28:31], s17 offen offset:256 nt
    s_memrealtime s[80:81]
    s_waitcnt vmcnt(5) lgkmcnt(0)
    s_sub_u32 s80, s80, s19
    s_cmpk_gt_i32 s80, 603
    s_cbranch_scc1 L_deep_14
    s_sub_u32 s19, s19, 2
    s_waitcnt vmcnt(3)
L_deep_14:
    buffer_load_dwordx4 v[200:203], v4, s[28:31], s17 offen offset:3072 nt
    s_memrealtime s[80:81]
    s_waitcnt vmcnt(5) lgkmcnt(0)
    s_sub_u32 s80, s80, s19
    s_cmpk_gt_i32 s80, 678
    s_cbranch_scc1 L_deep_15
    s_sub_u32 s19, s19, 2
    s_waitcnt vmcnt(4)
L_deep_15:
    buffer_load_dwordx4 v[204:207], v4, s[28:31], s17 offen offset:3200 nt
    s_memrealtime s[80:81]
    s_waitcnt vmcnt(5) lgkmcnt(0)
    s_sub_u32 s80, s80, s19
    s_cmpk_gt_i32 s80, 687
    s_cbranch_scc1 L_deep_16
    s_sub_u32 s19, s19, 2
    s_waitcnt vmcnt(2)
L_deep_16:
    buffer_load_dwordx4 v[208:211], v4, s[28:31], s17 offen offset:3328 nt
    s_memrealtime s[80:81]
    s_waitcnt vmcnt(4)
L_x1chk:
    v_xor_b32 v40, s72, v40
    v_xor_b32 v41, s73, v41
    v_xor_b32 v42, s74, v42
    v_xor_b32 v43, s75, v43
    v_xor_b32 v44, v28, v44
    v_xor_b32 v45, v29, v45
    v_xor_b32 v46, v30, v46
    v_xor_b32 v47, v31, v47
    v_or3_b32 v48, v40, v41, v42
    v_or_b32 v48, v48, v43
    v_or3_b32 v49, v44, v45, v46
    v_or_b32 v49, v49, v47
    v_and_b32 v48, 0xff, v48
    v_and_or_b32 v48, v49, v32, v48
    v_cmp_ne_u32 vcc, 0, v48
    s_cbranch_vccnz L_x1slow
L_x1ok:
    v_add_f32_dpp v40, v40, v40 quad_perm:[1,0,3,2] row_mask:0xf bank_mask:0xf
    v_add_f32_dpp v41, v41, v41 quad_perm:[1,0,3,2] row_mask:0xf bank_mask:0xf
    v_add_f32_dpp v42, v42, v42 quad_perm:[1,0,3,2] row_mask:0xf bank_mask:0xf
    v_add_f32_dpp v43, v43, v43 quad_perm:[1,0,3,2] row_mask:0xf bank_mask:0xf
    v_add_f32_dpp v40, v40, v40 quad_perm:[2,3,0,1] row_mask:0xf bank_mask:0xf
    v_add_f32_dpp v41, v41, v41 quad_perm:[2,3,0,1] row_mask:0xf bank_mask:0xf
    v_add_f32_dpp v42, v42, v42 quad_perm:[2,3,0,1] row_mask:0xf bank_mask:0xf
    v_add_f32_dpp v43, v43, v43 quad_perm:[2,3,0,1] row_mask:0xf bank_mask:0xf
    v_add_f32_dpp v40, v40, v40 row_half_mirror row_mask:0xf bank_mask:0xf
    v_add_f32_dpp v41, v41, v41 row_half_mirror row_mask:0xf bank_mask:0xf
    v_add_f32_dpp v42, v42, v42 row_half_mirror row_mask:0xf bank_mask:0xf
    v_add_f32_dpp v43, v43, v43 row_half_mirror row_mask:0xf bank_mask:0xf
    s_min_u32 s59, s52, 5
    s_lshl_b32 s59, s59, 6
    v_cvt_pk_bf16_f32 v40, v40, v41
    v_cvt_pk_bf16_f32 v41, v42, v43
    v_lshl_add_u32 v50, v2, 3, s59
    ds_write_b64 v50, v[40:41] offset:24576
    s_mov_b64 exec, 1
    ds_add_u32 v22, v23 offset:25092
    s_mov_b64 exec, -1
    s_waitcnt vmcnt(3) lgkmcnt(0)
    s_sub_u32 s80, s80, s19
    s_cmpk_gt_i32 s80, 692
    s_cbranch_scc1 L_deep_17
    s_sub_u32 s19, s19, 2
    s_waitcnt vmcnt(1)
L_deep_17:
    buffer_load_dwordx4 v[212:215], v4, s[28:31], s18 offen offset:0 nt
    s_memrealtime s[80:81]
    v_add_f32_dpp v44, v44, v44 quad_perm:[1,0,3,2] row_mask:0xf bank_mask:0xf
    v_add_f32_dpp v45, v45, v45 quad_perm:[1,0,3,2] row_mask:0xf bank_mask:0xf
    v_add_f32_dpp v46, v46, v46 quad_perm:[1,0,3,2] row_mask:0xf bank_mask:0xf
    v_add_f32_dpp v47, v47, v47 quad_perm:[1,0,3,2] row_mask:0xf bank_mask:0xf
    v_add_f32_dpp v44, v44, v44 quad_perm:[2,3,0,1] row_mask:0xf bank_mask:0xf
    v_add_f32_dpp v45, v45, v45 quad_perm:[2,3,0,1] row_mask:0xf bank_mask:0xf
    v_add_f32_dpp v46, v46, v46 quad_perm:[2,3,0,1] row_mask:0xf bank_mask:0xf
    v_add_f32_dpp v47, v47, v47 quad_perm:[2,3,0,1] row_mask:0xf bank_mask:0xf
    v_add_f32_dpp v44, v44, v44 row_half_mirror row_mask:0xf bank_mask:0xf
    v_add_f32_dpp v45, v45, v45 row_half_mirror row_mask:0xf bank_mask:0xf
    v_add_f32_dpp v46, v46, v46 row_half_mirror row_mask:0xf bank_mask:0xf
    v_add_f32_dpp v47, v47, v47 row_half_mirror row_mask:0xf bank_mask:0xf
    v_add_f32_dpp v44, v44, v44 row_mirror row_mask:0xf bank_mask:0xf
    v_add_f32_dpp v45, v45, v45 row_mirror row_mask:0xf bank_mask:0xf
    v_add_f32_dpp v46, v46, v46 row_mirror row_mask:0xf bank_mask:0xf
    v_add_f32_dpp v47, v47, v47 row_mirror row_mask:0xf bank_mask:0xf
    v_and_b32 v48, 1, v2
    v_cmp_eq_u32 vcc, 1, v48
    v_lshlrev_b32 v51, 4, v3
    s_cmp_lt_u32 s52, 6
    s_cselect_b32 s59, 0, 1073741824
    v_cndmask_b32 v44, v44, v45, vcc
    v_cndmask_b32 v46, v46, v47, vcc
    v_or_b32 v12, s59, v12
    s_waitcnt vmcnt(3) lgkmcnt(0)
    s_sub_u32 s80, s80, s19
    s_cmpk_gt_i32 s80, 767
    s_cbranch_scc1 L_deep_18
    s_sub_u32 s19, s19, 2
    s_waitcnt vmcnt(2)
L_deep_18:
    buffer_load_dwordx4 v[216:219], v4, s[28:31], s18 offen offset:128 nt
    s_memrealtime s[80:81]
    v_cvt_pk_bf16_f32 v44, v44, v44
    v_and_b32 v44, 0xffff0000, v44
    v_cvt_pk_bf16_f32 v46, v46, v46
    v_and_b32 v46, 0xffff0000, v46
    s_nop 1
    v_permlane16_swap_b32 v44, v46
    v_mul_f32 v48, 0xbfb8aa3b, v44
    v_exp_f32 v48, v48
    s_nop 0
    v_add_f32 v48, 1.0, v48
    v_rcp_f32 v48, v48
    s_nop 0
    v_mul_f32 v48, v48, v44
    v_cvt_pk_bf16_f32 v48, v48, v48
    v_and_b32 v48, 0xffff0000, v48
    v_mul_f32 v48, v48, v46
    v_cvt_pk_bf16_f32 v48, v48, v48
    v_and_b32 v36, v48, v24
    v_and_b32 v37, v48, v25
    v_and_b32 v38, v48, v26
    v_and_b32 v39, v48, v27
    s_waitcnt vmcnt(3) lgkmcnt(0)
    s_sub_u32 s80, s80, s19
    s_cmpk_gt_i32 s80, 776
    s_cbranch_scc1 L_deep_19
    s_sub_u32 s19, s19, 2
    s_waitcnt vmcnt(2)
L_deep_19:
    buffer_load_dwordx4 v[220:223], v4, s[28:31], s18 offen offset:256 nt
    s_memrealtime s[80:81]
L_await_20:
    ds_read_b32 v19, v22 offset:25092
    ds_read_b128 v[68:71], v51 offset:24576
    ds_read_b128 v[72:75], v51 offset:24704
    ds_read_b128 v[76:79], v51 offset:24832
    s_sub_u32 s63, s63, 1
    s_cbranch_scc1 L_end
    s_waitcnt lgkmcnt(0)
    v_cmp_ne_u32 vcc, 8, v19
    s_cbranch_vccnz L_await_20
    v_dot2_f32_bf16 v60, v140, v68, 0
    v_dot2_f32_bf16 v48, v141, v69, 0
    v_dot2_f32_bf16 v60, v142, v70, v60
    v_dot2_f32_bf16 v48, v143, v71, v48
    v_dot2_f32_bf16 v60, v144, v72, v60
    v_dot2_f32_bf16 v48, v145, v73, v48
    v_dot2_f32_bf16 v60, v146, v74, v60
    v_dot2_f32_bf16 v48, v147, v75, v48
    v_dot2_f32_bf16 v60, v148, v76, v60
    v_dot2_f32_bf16 v48, v149, v77, v48
    v_dot2_f32_bf16 v60, v150, v78, v60
    v_dot2_f32_bf16 v48, v151, v79, v48
    v_dot2_f32_bf16 v61, v152, v68, 0
    v_dot2_f32_bf16 v49, v153, v69, 0
    v_dot2_f32_bf16 v61, v154, v70, v61
    v_dot2_f32_bf16 v49, v155, v71, v49
    v_dot2_f32_bf16 v61, v156, v72, v61
    v_dot2_f32_bf16 v49, v157, v73, v49
    v_dot2_f32_bf16 v61, v158, v74, v61
    v_dot2_f32_bf16 v49, v159, v75, v49
    v_dot2_f32_bf16 v61, v160, v76, v61
    v_dot2_f32_bf16 v49, v161, v77, v49
    v_dot2_f32_bf16 v61, v162, v78, v61
    v_dot2_f32_bf16 v49, v163, v79, v49
    s_waitcnt vmcnt(3) lgkmcnt(0)
    s_sub_u32 s80, s80, s19
    s_cmpk_gt_i32 s80, 781
    s_cbranch_scc1 L_deep_21
    s_sub_u32 s19, s19, 2
    s_waitcnt vmcnt(1)
L_deep_21:
    buffer_load_dwordx4 v[224:227], v4, s[28:31], s18 offen offset:3072 nt
    s_memrealtime s[80:81]
    v_dot2_f32_bf16 v62, v164, v68, 0
    v_dot2_f32_bf16 v50, v165, v69, 0
    v_dot2_f32_bf16 v62, v166, v70, v62
    v_dot2_f32_bf16 v50, v167, v71, v50
    v_dot2_f32_bf16 v62, v168, v72, v62
    v_dot2_f32_bf16 v50, v169, v73, v50
    v_dot2_f32_bf16 v62, v170, v74, v62
    v_dot2_f32_bf16 v50, v171, v75, v50
    v_dot2_f32_bf16 v62, v172, v76, v62
    v_dot2_f32_bf16 v50, v173, v77, v50
    v_dot2_f32_bf16 v62, v174, v78, v62
    v_dot2_f32_bf16 v50, v175, v79, v50
    v_dot2_f32_bf16 v63, v176, v68, 0
    v_dot2_f32_bf16 v51, v177, v69, 0
    v_dot2_f32_bf16 v63, v178, v70, v63
    v_dot2_f32_bf16 v51, v179, v71, v51
    v_dot2_f32_bf16 v63, v180, v72, v63
    v_dot2_f32_bf16 v51, v181, v73, v51
    v_dot2_f32_bf16 v63, v182, v74, v63
    v_dot2_f32_bf16 v51, v183, v75, v51
    v_dot2_f32_bf16 v63, v184, v76, v63
    v_dot2_f32_bf16 v51, v185, v77, v51
    v_dot2_f32_bf16 v63, v186, v78, v63
    v_dot2_f32_bf16 v51, v187, v79, v51
    s_waitcnt vmcnt(3) lgkmcnt(0)
    s_sub_u32 s80, s80, s19
    s_cmpk_gt_i32 s80, 855
    s_cbranch_scc1 L_deep_22
    s_sub_u32 s19, s19, 2
    s_waitcnt vmcnt(2)
L_deep_22:
    buffer_load_dwordx4 v[228:231], v4, s[28:31], s18 offen offset:3200 nt
    s_memrealtime s[80:81]
    v_add_f32 v60, v60, v48
    v_add_f32 v61, v61, v49
    v_add_f32 v62, v62, v50
    v_add_f32 v63, v63, v51
    v_add_f32_dpp v60, v60, v60 quad_perm:[1,0,3,2] row_mask:0xf bank_mask:0xf
    v_add_f32_dpp v61, v61, v61 quad_perm:[1,0,3,2] row_mask:0xf bank_mask:0xf
    v_add_f32_dpp v62, v62, v62 quad_perm:[1,0,3,2] row_mask:0xf bank_mask:0xf
    v_add_f32_dpp v63, v63, v63 quad_perm:[1,0,3,2] row_mask:0xf bank_mask:0xf
    v_add_f32_dpp v60, v60, v60 quad_perm:[2,3,0,1] row_mask:0xf bank_mask:0xf
    v_add_f32_dpp v61, v61, v61 quad_perm:[2,3,0,1] row_mask:0xf bank_mask:0xf
    v_add_f32_dpp v62, v62, v62 quad_perm:[2,3,0,1] row_mask:0xf bank_mask:0xf
    v_add_f32_dpp v63, v63, v63 quad_perm:[2,3,0,1] row_mask:0xf bank_mask:0xf
    v_add_f32_dpp v60, v60, v60 row_half_mirror row_mask:0xf bank_mask:0xf
    v_add_f32_dpp v61, v61, v61 row_half_mirror row_mask:0xf bank_mask:0xf
    v_add_f32_dpp v62, v62, v62 row_half_mirror row_mask:0xf bank_mask:0xf
    v_add_f32_dpp v63, v63, v63 row_half_mirror row_mask:0xf bank_mask:0xf
    v_cvt_pk_bf16_f32 v61, v60, v61
    v_cvt_pk_bf16_f32 v63, v62, v63
    v_lshlrev_b32 v60, 16, v61
    v_and_b32 v61, 0xffff0000, v61
    v_lshlrev_b32 v62, 16, v63
    v_and_b32 v63, 0xffff0000, v63
    v_mul_f32 v60, 0x3d93cd3a, v60
    v_mul_f32 v61, 0x3d93cd3a, v61
    v_mul_f32 v62, 0x3d93cd3a, v62
    v_mul_f32 v63, 0x3d93cd3a, v63
    v_cvt_pk_bf16_f32 v61, v60, v61
    v_cvt_pk_bf16_f32 v63, v62, v63
    v_lshlrev_b32 v60, 16, v61
    v_and_b32 v61, 0xffff0000, v61
    v_lshlrev_b32 v62, 16, v63
    v_and_b32 v63, 0xffff0000, v63
    s_waitcnt vmcnt(3) lgkmcnt(0)
    s_sub_u32 s80, s80, s19
    s_cmpk_gt_i32 s80, 865
    s_cbranch_scc1 L_deep_23
    s_sub_u32 s19, s19, 2
    s_waitcnt vmcnt(2)
L_deep_23:
    buffer_load_dwordx4 v[232:235], v4, s[28:31], s18 offen offset:3328 nt
    s_memrealtime s[80:81]
    v_dot2_f32_bf16 v64, v188, v68, 0
    v_dot2_f32_bf16 v52, v189, v69, 0
    v_dot2_f32_bf16 v64, v190, v70, v64
    v_dot2_f32_bf16 v52, v191, v71, v52
    v_dot2_f32_bf16 v64, v192, v72, v64
    v_dot2_f32_bf16 v52, v193, v73, v52
    v_dot2_f32_bf16 v64, v194, v74, v64
    v_dot2_f32_bf16 v52, v195, v75, v52
    v_dot2_f32_bf16 v64, v196, v76, v64
    v_dot2_f32_bf16 v52, v197, v77, v52
    v_dot2_f32_bf16 v64, v198, v78, v64
    v_dot2_f32_bf16 v52, v199, v79, v52
    v_dot2_f32_bf16 v65, v200, v68, 0
    v_dot2_f32_bf16 v53, v201, v69, 0
    v_dot2_f32_bf16 v65, v202, v70, v65
    v_dot2_f32_bf16 v53, v203, v71, v53
    v_dot2_f32_bf16 v65, v204, v72, v65
    v_dot2_f32_bf16 v53, v205, v73, v53
    v_dot2_f32_bf16 v65, v206, v74, v65
    v_dot2_f32_bf16 v53, v207, v75, v53
    v_dot2_f32_bf16 v65, v208, v76, v65
    v_dot2_f32_bf16 v53, v209, v77, v53
    v_dot2_f32_bf16 v65, v210, v78, v65
    v_dot2_f32_bf16 v53, v211, v79, v53
    s_waitcnt vmcnt(3) lgkmcnt(0)
    s_sub_u32 s80, s80, s19
    s_cmpk_gt_i32 s80, 870
    s_cbranch_scc1 L_deep_24
    s_sub_u32 s19, s19, 2
    s_waitcnt vmcnt(1)
L_deep_24:
    buffer_load_dwordx4 v[116:119], v4, s[32:35], 0 offen offset:0 nt
    s_memrealtime s[80:81]
    v_dot2_f32_bf16 v66, v212, v68, 0
    v_dot2_f32_bf16 v54, v213, v69, 0
    v_dot2_f32_bf16 v66, v214, v70, v66
    v_dot2_f32_bf16 v54, v215, v71, v54
    v_dot2_f32_bf16 v66, v216, v72, v66
    v_dot2_f32_bf16 v54, v217, v73, v54
    v_dot2_f32_bf16 v66, v218, v74, v66
    v_dot2_f32_bf16 v54, v219, v75, v54
    v_dot2_f32_bf16 v66, v220, v76, v66
    v_dot2_f32_bf16 v54, v221, v77, v54
    v_dot2_f32_bf16 v66, v222, v78, v66
    v_dot2_f32_bf16 v54, v223, v79, v54
    s_waitcnt vmcnt(3) lgkmcnt(0)
    s_sub_u32 s80, s80, s19
    s_cmpk_gt_i32 s80, 944
    s_cbranch_scc1 L_deep_25
    s_sub_u32 s19, s19, 2
    s_waitcnt vmcnt(2)
L_deep_25:
    buffer_load_dwordx4 v[120:123], v4, s[32:35], 0 offen offset:128 nt
    s_memrealtime s[80:81]
    s_waitcnt vmcnt(3) lgkmcnt(0)
    s_sub_u32 s80, s80, s19
    s_cmpk_gt_i32 s80, 954
    s_cbranch_scc1 L_deep_26
    s_sub_u32 s19, s19, 2
    s_waitcnt vmcnt(2)
L_deep_26:
    buffer_load_dwordx4 v[124:127], v4, s[32:35], 0 offen offset:256 nt
    s_memrealtime s[80:81]
    s_waitcnt vmcnt(3) lgkmcnt(0)
    s_sub_u32 s80, s80, s19
    s_cmpk_gt_i32 s80, 958
    s_cbranch_scc1 L_deep_27
    s_sub_u32 s19, s19, 2
    s_waitcnt vmcnt(1)
L_deep_27:
    buffer_load_dwordx4 v[128:131], v4, s[32:35], 0 offen offset:3072 nt
    s_memrealtime s[80:81]
    v_dot2_f32_bf16 v67, v224, v68, 0
    v_dot2_f32_bf16 v55, v225, v69, 0
    v_dot2_f32_bf16 v67, v226, v70, v67
    v_dot2_f32_bf16 v55, v227, v71, v55
    v_dot2_f32_bf16 v67, v228, v72, v67
    v_dot2_f32_bf16 v55, v229, v73, v55
    v_dot2_f32_bf16 v67, v230, v74, v67
    v_dot2_f32_bf16 v55, v231, v75, v55
    v_dot2_f32_bf16 v67, v232, v76, v67
    v_dot2_f32_bf16 v55, v233, v77, v55
    v_dot2_f32_bf16 v67, v234, v78, v67
    v_dot2_f32_bf16 v55, v235, v79, v55
    s_waitcnt vmcnt(3) lgkmcnt(0)
    s_sub_u32 s80, s80, s19
    s_cmpk_gt_i32 s80, 1033
    s_cbranch_scc1 L_deep_28
    s_sub_u32 s19, s19, 2
    s_waitcnt vmcnt(2)
L_deep_28:
    buffer_load_dwordx4 v[132:135], v4, s[32:35], 0 offen offset:3200 nt
    s_memrealtime s[80:81]
    v_add_f32 v64, v64, v52
    v_add_f32 v65, v65, v53
    v_add_f32 v66, v66, v54
    v_add_f32 v67, v67, v55
    v_add_f32_dpp v64, v64, v64 quad_perm:[1,0,3,2] row_mask:0xf bank_mask:0xf
    v_add_f32_dpp v65, v65, v65 quad_perm:[1,0,3,2] row_mask:0xf bank_mask:0xf
    v_add_f32_dpp v66, v66, v66 quad_perm:[1,0,3,2] row_mask:0xf bank_mask:0xf
    v_add_f32_dpp v67, v67, v67 quad_perm:[1,0,3,2] row_mask:0xf bank_mask:0xf
    v_add_f32_dpp v64, v64, v64 quad_perm:[2,3,0,1] row_mask:0xf bank_mask:0xf
    v_add_f32_dpp v65, v65, v65 quad_perm:[2,3,0,1] row_mask:0xf bank_mask:0xf
    v_add_f32_dpp v66, v66, v66 quad_perm:[2,3,0,1] row_mask:0xf bank_mask:0xf
    v_add_f32_dpp v67, v67, v67 quad_perm:[2,3,0,1] row_mask:0xf bank_mask:0xf
    v_add_f32_dpp v64, v64, v64 row_half_mirror row_mask:0xf bank_mask:0xf
    v_add_f32_dpp v65, v65, v65 row_half_mirror row_mask:0xf bank_mask:0xf
    v_add_f32_dpp v66, v66, v66 row_half_mirror row_mask:0xf bank_mask:0xf
    v_add_f32_dpp v67, v67, v67 row_half_mirror row_mask:0xf bank_mask:0xf
    v_cvt_pk_bf16_f32 v65, v64, v65
    v_cvt_pk_bf16_f32 v67, v66, v67
    v_lshlrev_b32 v64, 16, v65
    v_and_b32 v65, 0xffff0000, v65
    v_lshlrev_b32 v66, 16, v67
    v_and_b32 v67, 0xffff0000, v67
    v_mul_f32 v64, 0x3d93cd3a, v64
    v_mul_f32 v65, 0x3d93cd3a, v65
    v_mul_f32 v66, 0x3d93cd3a, v66
    v_mul_f32 v67, 0x3d93cd3a, v67
    v_cvt_pk_bf16_f32 v65, v64, v65
    v_cvt_pk_bf16_f32 v67, v66, v67
    v_lshlrev_b32 v64, 16, v65
    v_and_b32 v65, 0xffff0000, v65
    v_lshlrev_b32 v66, 16, v67
    v_and_b32 v67, 0xffff0000, v67
    s_waitcnt vmcnt(3) lgkmcnt(0)
    s_sub_u32 s80, s80, s19
    s_cmpk_gt_i32 s80, 1043
    s_cbranch_scc1 L_deep_29
    s_sub_u32 s19, s19, 2
    s_waitcnt vmcnt(2)
L_deep_29:
    buffer_load_dwordx4 v[136:139], v4, s[32:35], 0 offen offset:3328 nt
    s_memrealtime s[80:81]
    v_max3_f32 v40, v60, v61, v62
    v_max3_f32 v41, v63, v64, v65
    v_max3_f32 v40, v40, v66, v67
    v_max_f32 v40, v40, v41
    s_nop 1
    v_max_f32_dpp v40, v40, v40 row_ror:8 row_mask:0xf bank_mask:0xf
    s_nop 1
    v_max_f32_dpp v40, v40, v40 row_bcast:15 row_mask:0xa bank_mask:0xf
    s_nop 1
    v_max_f32_dpp v40, v40, v40 row_bcast:31 row_mask:0xc bank_mask:0xf
    s_nop 0
    v_readlane_b32 s76, v40, 63
    s_nop 1
    v_subrev_f32 v60, s76, v60
    v_subrev_f32 v61, s76, v61
    v_subrev_f32 v62, s76, v62
    v_subrev_f32 v63, s76, v63
    v_subrev_f32 v64, s76, v64
    v_subrev_f32 v65, s76, v65
    v_subrev_f32 v66, s76, v66
    v_subrev_f32 v67, s76, v67
    v_mul_f32 v60, 0x3fb8aa3b, v60
    v_mul_f32 v61, 0x3fb8aa3b, v61
    v_mul_f32 v62, 0x3fb8aa3b, v62
    v_mul_f32 v63, 0x3fb8aa3b, v63
    v_mul_f32 v64, 0x3fb8aa3b, v64
    v_mul_f32 v65, 0x3fb8aa3b, v65
    v_mul_f32 v66, 0x3fb8aa3b, v66
    v_mul_f32 v67, 0x3fb8aa3b, v67
    s_waitcnt vmcnt(3) lgkmcnt(0)
    s_sub_u32 s80, s80, s19
    s_cmpk_gt_i32 s80, 1047
    s_cbranch_scc1 L_deep_30
    s_sub_u32 s19, s19, 2
    s_waitcnt vmcnt(1)
L_deep_30:
    buffer_load_dwordx4 v[140:143], v4, s[32:35], s16 offen offset:0 nt
    s_memrealtime s[80:81]
    v_exp_f32 v60, v60
    v_exp_f32 v61, v61
    v_exp_f32 v62, v62
    v_exp_f32 v63, v63
    v_exp_f32 v64, v64
    v_exp_f32 v65, v65
    v_exp_f32 v66, v66
    v_exp_f32 v67, v67
    v_add_f32 v48, v60, v64
    v_add_f32 v49, v61, v65
    v_add_f32 v50, v62, v66
    v_add_f32 v51, v63, v67
    v_add_f32 v48, v48, v49
    v_add_f32 v50, v50, v51
    v_add_f32 v41, v48, v50
    s_and_b32 s61, s70, 0xffff
    s_lshl_b32 s59, s55, 3
    s_add_u32 s59, s59, s52
    s_lshl_b32 s59, s59, 3
    v_add_f32_dpp v41, v41, v41 row_ror:8 row_mask:0xf bank_mask:0xf
    s_nop 1
    v_add_f32_dpp v41, v41, v41 row_bcast:15 row_mask:0xa bank_mask:0xf
    s_nop 1
    v_add_f32_dpp v41, v41, v41 row_bcast:31 row_mask:0xc bank_mask:0xf
    s_add_u32 s59, s59, 327680
    v_mov_b32 v48, s59
    v_or_b32 v40, s61, v40
    v_and_b32 v41, 0xffffff00, v41
    v_or_b32 v41, s74, v41
    s_mov_b32 exec_lo, 0
    s_mov_b32 exec_hi, 0x80000000
    s_cmp_lg_u32 s64, 0
    s_cbranch_scc1 L_pubslow_31
    buffer_store_dwordx2 v[40:41], v48, s[40:43], s64 offen
L_pubback_32:
    s_mov_b64 exec, -1
    s_lshl_b32 s59, s54, 3
    s_add_u32 s59, s59, s53
    s_sub_u32 s59, s59, 240
    s_lshl_b32 s60, s52, 8
    s_or_b32 s60, s60, s59
    s_cmp_lt_u32 s60, 10
    s_cbranch_scc1 L_park
L_parkback:
    s_waitcnt vmcnt(4) lgkmcnt(0)
    s_sub_u32 s80, s80, s19
    s_cmpk_gt_i32 s80, 1122
    s_cbranch_scc1 L_deep_33
    s_sub_u32 s19, s19, 2
    s_waitcnt vmcnt(3)
L_deep_33:
    buffer_load_dwordx4 v[144:147], v4, s[32:35], s16 offen offset:128 nt
    s_memrealtime s[80:81]
    s_waitcnt vmcnt(4) lgkmcnt(0)
    s_sub_u32 s80, s80, s19
    s_cmpk_gt_i32 s80, 1131
    s_cbranch_scc1 L_deep_34
    s_sub_u32 s19, s19, 2
    s_waitcnt vmcnt(3)
L_deep_34:
    buffer_load_dwordx4 v[148:151], v4, s[32:35], s16 offen offset:256 nt
    s_memrealtime s[80:81]
    s_waitcnt vmcnt(4) lgkmcnt(0)
    s_sub_u32 s80, s80, s19
    s_cmpk_gt_i32 s80, 1136
    s_cbranch_scc1 L_deep_35
    s_sub_u32 s19, s19, 2
    s_waitcnt vmcnt(1)
L_deep_35:
    buffer_load_dwordx4 v[152:155], v4, s[32:35], s16 offen offset:3072 nt
    s_memrealtime s[80:81]
    s_waitcnt vmcnt(4) lgkmcnt(0)
    s_sub_u32 s80, s80, s19
    s_cmpk_gt_i32 s80, 1211
    s_cbranch_scc1 L_deep_36
    s_sub_u32 s19, s19, 2
    s_waitcnt vmcnt(2)
L_deep_36:
    buffer_load_dwordx4 v[156:159], v4, s[32:35], s16 offen offset:3200 nt
    s_memrealtime s[80:81]
    s_waitcnt vmcnt(3) lgkmcnt(0)
    s_sub_u32 s80, s80, s19
    s_cmpk_gt_i32 s80, 1220
    s_cbranch_scc1 L_deep_37
    s_sub_u32 s19, s19, 2
    s_waitcnt vmcnt(2)
L_deep_37:
    buffer_load_dwordx4 v[160:163], v4, s[32:35], s16 offen offset:3328 nt
    s_memrealtime s[80:81]
    s_waitcnt vmcnt(3) lgkmcnt(0)
    s_sub_u32 s80, s80, s19
    s_cmpk_gt_i32 s80, 1225
    s_cbranch_scc1 L_deep_38
    s_sub_u32 s19, s19, 2
    s_waitcnt vmcnt(1)
L_deep_38:
    buffer_load_dwordx4 v[164:167], v4, s[32:35], s17 offen offset:0 nt
    s_memrealtime s[80:81]
    s_waitcnt vmcnt(3) lgkmcnt(0)
    s_sub_u32 s80, s80, s19
    s_cmpk_gt_i32 s80, 1299
    s_cbranch_scc1 L_deep_39
    s_sub_u32 s19, s19, 2
    s_waitcnt vmcnt(2)
L_deep_39:
    buffer_load_dwordx4 v[168:171], v4, s[32:35], s17 offen offset:128 nt
    s_memrealtime s[80:81]
    s_lshl_b32 s59, s56, 9
    s_add_u32 s59, s59, 327680
    s_add_u32 s59, s59, s64
    v_lshlrev_b32 v18, 3, v1
    buffer_load_dwordx2 v[40:41], v18, s[40:43], s59 offen sc1
    s_waitcnt vmcnt(4) lgkmcnt(0)
    s_sub_u32 s80, s80, s19
    s_cmpk_gt_i32 s80, 1309
    s_cbranch_scc1 L_deep_40
    s_sub_u32 s19, s19, 2
    s_waitcnt vmcnt(3)
L_deep_40:
    buffer_load_dwordx4 v[172:175], v4, s[32:35], s17 offen offset:256 nt
    s_memrealtime s[80:81]
    s_waitcnt vmcnt(4) lgkmcnt(0)
    s_sub_u32 s80, s80, s19
    s_cmpk_gt_i32 s80, 1314
    s_cbranch_scc1 L_deep_41
    s_sub_u32 s19, s19, 2
    s_waitcnt vmcnt(2)
L_deep_41:
    buffer_load_dwordx4 v[176:179], v4, s[32:35], s17 offen offset:3072 nt
    s_memrealtime s[80:81]
    s_waitcnt vmcnt(4) lgkmcnt(0)
    s_sub_u32 s80, s80, s19
    s_cmpk_gt_i32 s80, 1388
    s_cbranch_scc1 L_deep_42
    s_sub_u32 s19, s19, 2
    s_waitcnt vmcnt(3)
L_deep_42:
    buffer_load_dwordx4 v[180:183], v4, s[32:35], s17 offen offset:3200 nt
    s_memrealtime s[80:81]
    s_waitcnt vmcnt(4) lgkmcnt(0)
    s_sub_u32 s80, s80, s19
    s_cmpk_gt_i32 s80, 1398
    s_cbranch_scc1 L_deep_43
    s_sub_u32 s19, s19, 2
    s_waitcnt vmcnt(2)
L_deep_43:
    buffer_load_dwordx4 v[184:187], v4, s[32:35], s17 offen offset:3328 nt
    s_memrealtime s[80:81]
    s_waitcnt vmcnt(4)
L_mlchk:
    v_xor_b32 v40, s61, v40
    v_xor_b32 v41, s74, v41
    v_and_b32 v48, 0xffff, v40
    v_and_b32 v49, 0xff, v41
    v_or_b32 v48, v48, v49
    v_cmp_ne_u32 vcc, 0, v48
    s_cbranch_vccnz L_retry_44
    v_max_f32_dpp v48, v40, v40 quad_perm:[1,0,3,2] row_mask:0xf bank_mask:0xf
    s_nop 1
    v_max_f32_dpp v48, v48, v48 quad_perm:[2,3,0,1] row_mask:0xf bank_mask:0xf
    s_nop 1
    v_max_f32_dpp v48, v48, v48 row_half_mirror row_mask:0xf bank_mask:0xf
    s_nop 1
    v_max_f32_dpp v48, v48, v48 row_ror:8 row_mask:0xf bank_mask:0xf
    s_nop 1
    v_max_f32_dpp v48, v48, v48 row_bcast:15 row_mask:0xa bank_mask:0xf
    s_nop 1
    v_max_f32_dpp v48, v48, v48 row_bcast:31 row_mask:0xc bank_mask:0xf
    s_nop 0
    v_readlane_b32 s59, v48, 63
    v_mov_b32 v49, s76
    s_waitcnt vmcnt(3) lgkmcnt(0)
    s_sub_u32 s80, s80, s19
    s_cmpk_gt_i32 s80, 1402
    s_cbranch_scc1 L_deep_45
    s_sub_u32 s19, s19, 2
    s_waitcnt vmcnt(1)
L_deep_45:
    buffer_load_dwordx4 v[188:191], v4, s[32:35], s18 offen offset:0 nt
    s_memrealtime s[80:81]
    v_subrev_f32 v48, s59, v40
    v_subrev_f32 v49, s59, v49
    v_mul_f32 v48, 0x3fb8aa3b, v48
    v_mul_f32 v49, 0x3fb8aa3b, v49
    v_exp_f32 v48, v48
    v_exp_f32 v49, v49
    v_mul_f32 v48, v48, v41
    s_nop 1
    v_add_f32_dpp v48, v48, v48 quad_perm:[1,0,3,2] row_mask:0xf bank_mask:0xf
    s_nop 1
    v_add_f32_dpp v48, v48, v48 quad_perm:[2,3,0,1] row_mask:0xf bank_mask:0xf
    s_nop 1
    v_add_f32_dpp v48, v48, v48 row_half_mirror row_mask:0xf bank_mask:0xf
    s_nop 1
    v_add_f32_dpp v48, v48, v48 row_ror:8 row_mask:0xf bank_mask:0xf
    s_nop 1
    v_add_f32_dpp v48, v48, v48 row_bcast:15 row_mask:0xa bank_mask:0xf
    s_nop 1
    v_add_f32_dpp v48, v48, v48 row_bcast:31 row_mask:0xc bank_mask:0xf
    v_rcp_f32 v48, v48
    s_nop 0
    v_mul_f32 v48, v48, v49
    s_nop 0
    v_readlane_b32 s60, v48, 63
    s_waitcnt vmcnt(3) lgkmcnt(0)
    s_sub_u32 s80, s80, s19
    s_cmpk_gt_i32 s80, 1477
    s_cbranch_scc1 L_deep_46
    s_sub_u32 s19, s19, 2
    s_waitcnt vmcnt(2)
L_deep_46:
    buffer_load_dwordx4 v[192:195], v4, s[32:35], s18 offen offset:128 nt
    s_memrealtime s[80:81]
    v_mul_f32 v60, s60, v60
    v_mul_f32 v61, s60, v61
    v_mul_f32 v62, s60, v62
    v_mul_f32 v63, s60, v63
    v_mul_f32 v64, s60, v64
    v_mul_f32 v65, s60, v65
    v_mul_f32 v66, s60, v66
    v_mul_f32 v67, s60, v67
    v_cvt_pk_bf16_f32 v60, v60, v60
    v_cvt_pk_bf16_f32 v61, v61, v61
    v_cvt_pk_bf16_f32 v62, v62, v62
    v_cvt_pk_bf16_f32 v63, v63, v63
    v_cvt_pk_bf16_f32 v64, v64, v64
    v_cvt_pk_bf16_f32 v65, v65, v65
    v_cvt_pk_bf16_f32 v66, v66, v66
    v_cvt_pk_bf16_f32 v67, v67, v67
    s_bfe_u32 s72, s58, 0x80000
    s_bfe_u32 s73, s58, 0x80008
    s_bfe_u32 s74, s58, 0x80010
    s_bfe_u32 s75, s58, 0x80018
    s_lshl_b32 s68, s65, 10
    s_add_u32 s68, s68, 65536
    s_add_u32 s68, s68, s64
    s_waitcnt vmcnt(3) lgkmcnt(0)
    s_sub_u32 s80, s80, s19
    s_cmpk_gt_i32 s80, 1487
    s_cbranch_scc1 L_deep_47
    s_sub_u32 s19, s19, 2
    s_waitcnt vmcnt(2)
L_deep_47:
    buffer_load_dwordx4 v[196:199], v4, s[32:35], s18 offen offset:256 nt
    s_memrealtime s[80:81]
    v_and_b32 v28, v60, v24
    v_and_b32 v29, v60, v25
    v_and_b32 v30, v60, v26
    v_and_b32 v31, v60, v27
    s_nop 1
    v_mfma_f32_16x16x32_bf16 v[80:83], v[28:31], v[116:119], 0
    v_mfma_f32_16x16x32_bf16 v[84:87], v[28:31], v[120:123], 0
    v_mfma_f32_16x16x32_bf16 v[88:91], v[28:31], v[124:127], 0
    v_and_b32 v32, v61, v24
    v_and_b32 v33, v61, v25
    v_and_b32 v34, v61, v26
    v_and_b32 v35, v61, v27
    s_nop 1
    v_mfma_f32_16x16x32_bf16 v[80:83], v[32:35], v[128:131], v[80:83]
    v_mfma_f32_16x16x32_bf16 v[84:87], v[32:35], v[132:135], v[84:87]
    v_mfma_f32_16x16x32_bf16 v[88:91], v[32:35], v[136:139], v[88:91]
    v_and_b32 v28, v62, v24
    v_and_b32 v29, v62, v25
    v_and_b32 v30, v62, v26
    v_and_b32 v31, v62, v27
    s_nop 1
    v_mfma_f32_16x16x32_bf16 v[80:83], v[28:31], v[140:143], v[80:83]
    v_mfma_f32_16x16x32_bf16 v[84:87], v[28:31], v[144:147], v[84:87]
    v_mfma_f32_16x16x32_bf16 v[88:91], v[28:31], v[148:151], v[88:91]
    s_waitcnt vmcnt(3) lgkmcnt(0)
    s_sub_u32 s80, s80, s19
    s_cmpk_gt_i32 s80, 1491
    s_cbranch_scc1 L_deep_48
    s_sub_u32 s19, s19, 2
    s_waitcnt vmcnt(1)
L_deep_48:
    buffer_load_dwordx4 v[200:203], v4, s[32:35], s18 offen offset:3072 nt
    s_memrealtime s[80:81]
    v_and_b32 v32, v63, v24
    v_and_b32 v33, v63, v25
    v_and_b32 v34, v63, v26
    v_and_b32 v35, v63, v27
    s_nop 1
    v_mfma_f32_16x16x32_bf16 v[80:83], v[32:35], v[152:155], v[80:83]
    v_mfma_f32_16x16x32_bf16 v[84:87], v[32:35], v[156:159], v[84:87]
    v_mfma_f32_16x16x32_bf16 v[88:91], v[32:35], v[160:163], v[88:91]
    v_and_b32 v28, v64, v24
    v_and_b32 v29, v64, v25
    v_and_b32 v30, v64, v26
    v_and_b32 v31, v64, v27
    s_nop 1
    v_mfma_f32_16x16x32_bf16 v[80:83], v[28:31], v[164:167], v[80:83]
    v_mfma_f32_16x16x32_bf16 v[84:87], v[28:31], v[168:171], v[84:87]
    v_mfma_f32_16x16x32_bf16 v[88:91], v[28:31], v[172:175], v[88:91]
    v_and_b32 v32, v65, v24
    v_and_b32 v33, v65, v25
    v_and_b32 v34, v65, v26
    v_and_b32 v35, v65, v27
    s_nop 1
    v_mfma_f32_16x16x32_bf16 v[80:83], v[32:35], v[176:179], v[80:83]
    v_mfma_f32_16x16x32_bf16 v[84:87], v[32:35], v[180:183], v[84:87]
    v_mfma_f32_16x16x32_bf16 v[88:91], v[32:35], v[184:187], v[88:91]
    v_and_b32 v28, v66, v24
    v_and_b32 v29, v66, v25
    v_and_b32 v30, v66, v26
    v_and_b32 v31, v66, v27
    s_waitcnt vmcnt(3) lgkmcnt(0)
    s_sub_u32 s80, s80, s19
    s_cmpk_gt_i32 s80, 1566
    s_cbranch_scc1 L_deep_49
    s_sub_u32 s19, s19, 2
    s_waitcnt vmcnt(2)
L_deep_49:
    buffer_load_dwordx4 v[204:207], v4, s[32:35], s18 offen offset:3200 nt
    s_memrealtime s[80:81]
    v_mfma_f32_16x16x32_bf16 v[80:83], v[28:31], v[188:191], v[80:83]
    s_waitcnt vmcnt(3) lgkmcnt(0)
    s_sub_u32 s80, s80, s19
    s_cmpk_gt_i32 s80, 1575
    s_cbranch_scc1 L_deep_50
    s_sub_u32 s19, s19, 2
    s_waitcnt vmcnt(2)
L_deep_50:
    buffer_load_dwordx4 v[208:211], v4, s[32:35], s18 offen offset:3328 nt
    s_memrealtime s[80:81]
    v_mfma_f32_16x16x32_bf16 v[84:87], v[28:31], v[192:195], v[84:87]
    s_waitcnt vmcnt(3) lgkmcnt(0)
    s_sub_u32 s80, s80, s19
    s_cmpk_gt_i32 s80, 1580
    s_cbranch_scc1 L_deep_51
    s_sub_u32 s19, s19, 2
    s_waitcnt vmcnt(1)
L_deep_51:
    buffer_load_dwordx4 v[92:95], v15, s[12:15], 0 offen offset:0 nt
    s_memrealtime s[80:81]
    v_mfma_f32_16x16x32_bf16 v[88:91], v[28:31], v[196:199], v[88:91]
    v_and_b32 v32, v67, v24
    v_and_b32 v33, v67, v25
    v_and_b32 v34, v67, v26
    v_and_b32 v35, v67, v27
    s_waitcnt vmcnt(3) lgkmcnt(0)
    s_sub_u32 s80, s80, s19
    s_cmpk_gt_i32 s80, 1655
    s_cbranch_scc1 L_deep_52
    s_sub_u32 s19, s19, 2
    s_waitcnt vmcnt(2)
L_deep_52:
    buffer_load_dwordx4 v[96:99], v15, s[12:15], 0 offen offset:1280 nt
    v_mfma_f32_16x16x32_bf16 v[80:83], v[32:35], v[200:203], v[80:83]
    s_mov_b64 exec, s[78:79]
    s_nop 6
    ds_write_b128 v9, v[80:83] offset:0
    s_mov_b64 exec, -1
    s_waitcnt vmcnt(3)
    buffer_load_dwordx4 v[100:103], v15, s[12:15], 0 offen offset:2560 nt
    v_mfma_f32_16x16x32_bf16 v[84:87], v[32:35], v[204:207], v[84:87]
    s_mov_b64 exec, s[78:79]
    s_nop 6
    ds_write_b128 v9, v[84:87] offset:256
    s_mov_b64 exec, -1
    s_waitcnt vmcnt(3)
    v_mfma_f32_16x16x32_bf16 v[88:91], v[32:35], v[208:211], v[88:91]
    s_mov_b64 exec, s[78:79]
    s_nop 6
    ds_write_b128 v9, v[88:91] offset:512
    s_mov_b64 exec, -1
    s_waitcnt lgkmcnt(0)
    s_barrier
    ds_read2st64_b32 v[48:49], v10 offset0:0 offset1:6
    ds_read2st64_b32 v[50:51], v10 offset0:12 offset1:18
    ds_read2st64_b32 v[52:53], v10 offset0:24 offset1:30
    ds_read2st64_b32 v[54:55], v10 offset0:36 offset1:42
    s_cmp_lg_u32 s64, 0
    s_waitcnt lgkmcnt(2)
    v_pk_add_f32 v[48:49], v[48:49], v[50:51]
    s_waitcnt lgkmcnt(1)
    v_pk_add_f32 v[48:49], v[48:49], v[52:53]
    s_waitcnt lgkmcnt(0)
    v_pk_add_f32 v[48:49], v[48:49], v[54:55]
    v_pk_add_f32 v[48:49], v[48:49], v[48:49] op_sel:[0,1] op_sel_hi:[1,0]
    s_nop 1
    v_permlane32_swap_b32 v48, v49
    v_add_f32 v48, v48, v49
    v_and_or_b32 v13, v48, s71, v14
    s_cbranch_scc1 L_pubslow_53
    buffer_store_dword v13, v12, s[40:43], s64 offen
L_pubback_54:
    s_barrier
    buffer_load_dwordx4 v[104:107], v15, s[12:15], 0 offen offset:3840 nt
    buffer_load_dwordx4 v[108:111], v16, s[20:23], 0 offen nt
    s_cmp_ge_u32 s54, 30
    s_cbranch_scc1 L_reducer
    s_waitcnt vmcnt(2)
    buffer_load_dwordx4 v[44:47], v11, s[40:43], s68 offen sc1
    s_waitcnt vmcnt(1)
    v_mfma_f32_16x16x32_bf16 v[56:59], v[36:39], v[108:111], 0
    s_branch L_ochk
L_opoll:
    buffer_load_dwordx4 v[44:47], v11, s[40:43], s68 offen sc1
    s_sub_u32 s63, s63, 1
    s_cbranch_scc1 L_end
L_ochk:
    s_waitcnt vmcnt(0)
    v_xor_b32 v44, s72, v44
    v_xor_b32 v45, s73, v45
    v_xor_b32 v46, s74, v46
    v_xor_b32 v47, s75, v47
    v_or3_b32 v48, v44, v45, v46
    v_or_b32 v48, v48, v47
    v_cmp_ne_u32_sdwa vcc, v48, v22 src0_sel:BYTE_0 src1_sel:DWORD
    v_add_f32_dpp v40, v44, v44 quad_perm:[1,0,3,2] row_mask:0xf bank_mask:0xf
    v_add_f32_dpp v41, v45, v45 quad_perm:[1,0,3,2] row_mask:0xf bank_mask:0xf
    v_add_f32_dpp v42, v46, v46 quad_perm:[1,0,3,2] row_mask:0xf bank_mask:0xf
    v_add_f32_dpp v43, v47, v47 quad_perm:[1,0,3,2] row_mask:0xf bank_mask:0xf
    s_cbranch_vccnz L_opoll
    v_add_f32_dpp v40, v40, v40 quad_perm:[2,3,0,1] row_mask:0xf bank_mask:0xf
    v_add_f32_dpp v41, v41, v41 quad_perm:[2,3,0,1] row_mask:0xf bank_mask:0xf
    v_add_f32_dpp v42, v42, v42 quad_perm:[2,3,0,1] row_mask:0xf bank_mask:0xf
    v_add_f32_dpp v43, v43, v43 quad_perm:[2,3,0,1] row_mask:0xf bank_mask:0xf
    v_add_f32_dpp v40, v40, v40 row_half_mirror row_mask:0xf bank_mask:0xf
    v_add_f32_dpp v41, v41, v41 row_half_mirror row_mask:0xf bank_mask:0xf
    v_add_f32_dpp v42, v42, v42 row_half_mirror row_mask:0xf bank_mask:0xf
    v_add_f32_dpp v43, v43, v43 row_half_mirror row_mask:0xf bank_mask:0xf
    v_cvt_pk_bf16_f32 v40, v40, v40
    v_cvt_pk_bf16_f32 v41, v41, v41
    v_cvt_pk_bf16_f32 v42, v42, v42
    v_cvt_pk_bf16_f32 v43, v43, v43
    v_and_b32 v28, v40, v24
    v_and_b32 v29, v40, v25
    v_and_b32 v30, v40, v26
    v_and_b32 v31, v40, v27
    v_and_b32 v32, v41, v24
    v_and_b32 v33, v41, v25
    v_and_b32 v34, v41, v26
    v_and_b32 v35, v41, v27
    v_mfma_f32_16x16x32_bf16 v[56:59], v[28:31], v[92:95], v[56:59]
    v_and_b32 v44, v42, v24
    v_and_b32 v45, v42, v25
    v_and_b32 v46, v42, v26
    v_and_b32 v47, v42, v27
    v_mfma_f32_16x16x32_bf16 v[56:59], v[32:35], v[96:99], v[56:59]
    v_and_b32 v48, v43, v24
    v_and_b32 v49, v43, v25
    v_and_b32 v50, v43, v26
    v_and_b32 v51, v43, v27
    v_mfma_f32_16x16x32_bf16 v[56:59], v[44:47], v[100:103], v[56:59]
    s_nop 0
    v_mfma_f32_16x16x32_bf16 v[56:59], v[48:51], v[104:107], v[56:59]
    s_mov_b64 exec, s[78:79]
    s_cmp_ge_u32 s52, 2
    s_nop 5
    ds_write_b128 v9, v[56:59] offset:12288
    s_mov_b64 exec, -1
    s_waitcnt lgkmcnt(0)
    s_barrier
    s_cbranch_scc1 L_exit3
    ds_read2st64_b32 v[48:49], v10 offset0:48 offset1:54
    ds_read2st64_b32 v[50:51], v10 offset0:60 offset1:66
    ds_read2st64_b32 v[52:53], v10 offset0:72 offset1:78
    ds_read2st64_b32 v[54:55], v10 offset0:84 offset1:90
    s_waitcnt lgkmcnt(2)
    v_pk_add_f32 v[48:49], v[48:49], v[50:51]
    s_waitcnt lgkmcnt(1)
    v_pk_add_f32 v[48:49], v[48:49], v[52:53]
    s_waitcnt lgkmcnt(0)
    v_pk_add_f32 v[48:49], v[48:49], v[54:55]
    v_pk_add_f32 v[48:49], v[48:49], v[48:49] op_sel:[0,1] op_sel_hi:[1,0]
    s_nop 1
    v_permlane32_swap_b32 v48, v49
    v_add_f32 v48, v48, v49
    v_and_or_b32 v13, v48, s71, v14
    buffer_store_dword v13, v17, s[40:43], 0 offen sc1
L_exit3:
    s_endpgm
L_reducer:
    s_lshl_b32 s66, s66, 3
    s_add_u32 s66, s66, s53
    s_cmp_ge_u32 s66, 10
    s_cbranch_scc1 L_exitr
    s_cmp_ge_u32 s52, 2
    s_cbranch_scc1 L_exitr
    s_lshl_b32 s59, s66, 2
    s_add_u32 s59, s59, s52
    s_lshl_b32 s59, s59, 12
    s_add_u32 s59, s59, 1048576
    s_lshl_b32 s66, s66, 1
    s_add_u32 s66, s66, s52
    s_cmp_eq_u32 s52, 0
    s_cselect_b32 s60, 0, 1073741824
    v_mov_b32 v49, s60
    v_or_b32 v50, 8192, v49
    s_waitcnt vmcnt(0)
    buffer_load_dword v51, v49, s[40:43], s59 offen offset:3072 sc1
    buffer_load_dword v55, v50, s[40:43], s59 offen offset:3072 sc1
    s_waitcnt vmcnt(1)
    v_lshrrev_b32 v49, 4, v1
    v_lshl_add_u32 v49, v3, 2, v49
    s_lshl_b32 s60, s66, 6
    v_lshl_add_u32 v17, v49, 1, s60
    s_cmp_eq_u32 s66, 0
    s_cselect_b32 s61, 0, 1073741824
    v_mov_b32 v52, s58
    v_mov_b32 v53, s61
    v_mov_b32 v54, v17
    s_lshl_b32 s60, s52, 2
    v_mov_b32 v49, s60
    s_getreg_b32 s4, hwreg(HW_REG_IB_STS, 0, 4)
    s_cmp_lg_u32 s4, 0
    s_cselect_b32 s4, 0, 8192
    v_mov_b32 v51, s4
    ds_write_b32 v49, v51 offset:24576
    s_waitcnt lgkmcnt(0)
    s_barrier
    ds_read_b32 v51, v22 offset:24576
    buffer_load_ushort v8, v17, s[44:47], 0 offen
    s_waitcnt lgkmcnt(0)
    v_add_u32 v11, v11, v51
    buffer_load_dwordx4 v[116:119], v11, s[40:43], s59 offen offset:0 sc1
    buffer_load_dwordx4 v[120:123], v11, s[40:43], s59 offen offset:1024 sc1
    buffer_load_dwordx4 v[124:127], v11, s[40:43], s59 offen offset:2048 sc1
    buffer_load_dwordx4 v[128:131], v11, s[40:43], s59 offen offset:0 sc1
    buffer_load_dwordx4 v[132:135], v11, s[40:43], s59 offen offset:1024 sc1
    buffer_load_dwordx4 v[136:139], v11, s[40:43], s59 offen offset:2048 sc1
    buffer_load_dwordx4 v[140:143], v11, s[40:43], s59 offen offset:0 sc1
    buffer_load_dwordx4 v[144:147], v11, s[40:43], s59 offen offset:1024 sc1
    buffer_load_dwordx4 v[148:151], v11, s[40:43], s59 offen offset:2048 sc1
    s_waitcnt vmcnt(9)
    v_lshlrev_b32 v8, 16, v8
L_ypoll:
    s_waitcnt vmcnt(6)
    v_xor_b32 v116, s72, v116
    v_xor_b32 v117, s73, v117
    v_xor_b32 v118, s74, v118
    v_xor_b32 v119, s75, v119
    v_xor_b32 v120, s72, v120
    v_xor_b32 v121, s73, v121
    v_xor_b32 v122, s74, v122
    v_xor_b32 v123, s75, v123
    v_xor_b32 v124, s72, v124
    v_xor_b32 v125, s73, v125
    v_xor_b32 v126, s74, v126
    v_xor_b32 v127, s75, v127
    v_or3_b32 v48, v116, v117, v118
    v_or3_b32 v48, v48, v119, v120
    v_or3_b32 v48, v48, v121, v122
    v_or3_b32 v48, v48, v123, v124
    v_or3_b32 v48, v48, v125, v126
    v_or_b32 v48, v48, v127
    v_cmp_ne_u32_sdwa vcc, v48, v22 src0_sel:BYTE_0 src1_sel:DWORD
    v_pk_add_f32 v[80:81], v[116:117], v[120:121]
    v_pk_add_f32 v[82:83], v[118:119], v[122:123]
    v_pk_add_f32 v[80:81], v[80:81], v[124:125]
    v_pk_add_f32 v[82:83], v[82:83], v[126:127]
    s_cbranch_vccz L_yfin
    buffer_load_dwordx4 v[116:119], v11, s[40:43], s59 offen offset:0 sc1
    buffer_load_dwordx4 v[120:123], v11, s[40:43], s59 offen offset:1024 sc1
    buffer_load_dwordx4 v[124:127], v11, s[40:43], s59 offen offset:2048 sc1
    s_waitcnt vmcnt(6)
    v_xor_b32 v128, s72, v128
    v_xor_b32 v129, s73, v129
    v_xor_b32 v130, s74, v130
    v_xor_b32 v131, s75, v131
    v_xor_b32 v132, s72, v132
    v_xor_b32 v133, s73, v133
    v_xor_b32 v134, s74, v134
    v_xor_b32 v135, s75, v135
    v_xor_b32 v136, s72, v136
    v_xor_b32 v137, s73, v137
    v_xor_b32 v138, s74, v138
    v_xor_b32 v139, s75, v139
    v_or3_b32 v48, v128, v129, v130
    v_or3_b32 v48, v48, v131, v132
    v_or3_b32 v48, v48, v133, v134
    v_or3_b32 v48, v48, v135, v136
    v_or3_b32 v48, v48, v137, v138
    v_or_b32 v48, v48, v139
    v_cmp_ne_u32_sdwa vcc, v48, v22 src0_sel:BYTE_0 src1_sel:DWORD
    v_pk_add_f32 v[80:81], v[128:129], v[132:133]
    v_pk_add_f32 v[82:83], v[130:131], v[134:135]
    v_pk_add_f32 v[80:81], v[80:81], v[136:137]
    v_pk_add_f32 v[82:83], v[82:83], v[138:139]
    s_cbranch_vccz L_yfin
    buffer_load_dwordx4 v[128:131], v11, s[40:43], s59 offen offset:0 sc1
    buffer_load_dwordx4 v[132:135], v11, s[40:43], s59 offen offset:1024 sc1
    buffer_load_dwordx4 v[136:139], v11, s[40:43], s59 offen offset:2048 sc1
    s_waitcnt vmcnt(6)
    v_xor_b32 v140, s72, v140
    v_xor_b32 v141, s73, v141
    v_xor_b32 v142, s74, v142
    v_xor_b32 v143, s75, v143
    v_xor_b32 v144, s72, v144
    v_xor_b32 v145, s73, v145
    v_xor_b32 v146, s74, v146
    v_xor_b32 v147, s75, v147
    v_xor_b32 v148, s72, v148
    v_xor_b32 v149, s73, v149
    v_xor_b32 v150, s74, v150
    v_xor_b32 v151, s75, v151
    v_or3_b32 v48, v140, v141, v142
    v_or3_b32 v48, v48, v143, v144
    v_or3_b32 v48, v48, v145, v146
    v_or3_b32 v48, v48, v147, v148
    v_or3_b32 v48, v48, v149, v150
    v_or_b32 v48, v48, v151
    v_cmp_ne_u32_sdwa vcc, v48, v22 src0_sel:BYTE_0 src1_sel:DWORD
    v_pk_add_f32 v[80:81], v[140:141], v[144:145]
    v_pk_add_f32 v[82:83], v[142:143], v[146:147]
    v_pk_add_f32 v[80:81], v[80:81], v[148:149]
    v_pk_add_f32 v[82:83], v[82:83], v[150:151]
    s_cbranch_vccz L_yfin
    buffer_load_dwordx4 v[140:143], v11, s[40:43], s59 offen offset:0 sc1
    buffer_load_dwordx4 v[144:147], v11, s[40:43], s59 offen offset:1024 sc1
    buffer_load_dwordx4 v[148:151], v11, s[40:43], s59 offen offset:2048 sc1
    s_sub_u32 s63, s63, 1
    s_cbranch_scc0 L_ypoll
    s_endpgm
L_yfin:
    buffer_store_dword v52, v53, s[40:43], 0 offen
    v_permlane32_swap_b32 v80, v82
    v_permlane32_swap_b32 v81, v83
    v_pk_add_f32 v[80:81], v[80:81], v[82:83]
    s_nop 1
    v_permlane16_swap_b32 v80, v81
    v_add_f32 v80, v80, v81
    s_nop 1
    v_add_f32_dpp v80, v80, v80 row_ror:8 row_mask:0xf bank_mask:0xf
    v_add_f32 v80, v80, v8
    v_cvt_pk_bf16_f32 v80, v80, v80
    buffer_store_short v80, v54, s[48:51], 0 offen
L_exitr:
    s_endpgm
L_x1slow:
    v_and_b32 v48, 0x0fffffff, v48
    v_cmp_ne_u32 vcc, 0, v48
    s_cbranch_vccnz L_x1wait
    s_mov_b32 s64, 327680
    v_not_b32 v48, v32
    v_and_b32 v44, v48, v44
    v_and_b32 v45, v48, v45
    v_and_b32 v46, v48, v46
    v_and_b32 v47, v48, v47
    buffer_store_dword v13, v12, s[40:43], s64 offen sc1
    s_branch L_x1ok
L_x1wait:
    s_sub_u32 s63, s63, 1
    s_cbranch_scc1 L_end
    s_sub_u32 s67, s67, 1
    s_cmp_lg_u32 s67, 0
    s_cbranch_scc1 L_x1nopub
    s_mov_b32 s59, 327680
    buffer_store_dword v13, v12, s[40:43], s59 offen sc1
L_x1nopub:
    s_and_b32 s59, s67, 0x80000001
    s_cmp_eq_u32 s59, 0x80000001
    s_cselect_b32 s59, 327680, 0
    s_add_u32 s60, s59, s69
    s_add_u32 s59, s59, s68
    buffer_load_dwordx4 v[40:43], v11, s[40:43], s59 offen sc1
    buffer_load_dwordx4 v[44:47], v18, s[40:43], s60 offen sc1
    s_waitcnt vmcnt(0)
    s_branch L_x1chk
L_pubslow_31:
    buffer_store_dwordx2 v[40:41], v48, s[40:43], s64 offen sc1
    s_branch L_pubback_32
L_park:
    s_lshl_b32 s59, s59, 14
    s_add_u32 s59, s59, 1051648
    v_and_b32 v48, 31, v1
    v_lshrrev_b32 v49, 5, v1
    v_lshlrev_b32 v49, 13, v49
    v_lshl_add_u32 v48, v48, 2, v49
    buffer_store_dword v22, v48, s[40:43], s59 offen sc1
    s_branch L_parkback
L_retry_44:
    s_sub_u32 s63, s63, 1
    s_cbranch_scc1 L_end
    buffer_load_dwordx2 v[40:41], v18, s[40:43], s59 offen sc1
    s_waitcnt vmcnt(0)
    s_branch L_mlchk
L_pubslow_53:
    buffer_store_dword v13, v12, s[40:43], s64 offen sc1
    s_branch L_pubback_54
L_end:
    s_endpgm
.section .rodata,"a"
.p2align 6
.amdhsa_kernel parallel_sum__gqa_block_cached__glu_gated_swiglu__decode_kernel
  .amdhsa_next_free_vgpr 240
  .amdhsa_next_free_sgpr 102
  .amdhsa_accum_offset 240
  .amdhsa_group_segment_fixed_size 0
  .amdhsa_kernarg_size 96
  .amdhsa_user_sgpr_count 2
  .amdhsa_user_sgpr_kernarg_segment_ptr 1
  .amdhsa_system_sgpr_workgroup_id_x 1
.end_amdhsa_kernel
```
